```python
import torch

def _softmax(x, axis=-1):
    return torch.softmax(x, dim=axis)
def _gelu(x):
    return torch.nn.functional.gelu(x, approximate="tanh")
def _silu(x):
    return torch.nn.functional.silu(x)
def _sigmoid(x):
    return torch.sigmoid(x)
def _layernorm(x, axis=-1, eps=1e-5):
    m = x.mean(dim=axis, keepdim=True)
    v = x.var(dim=axis, keepdim=True, unbiased=False)
    return (x - m) / torch.sqrt(v + eps)
def _scatter_add(tgt, idx, src, axis=0):
    return tgt.clone().index_add_(axis, idx, src)
def _segment_sum(src, seg, n):
    out = torch.zeros((n,) + src.shape[1:], dtype=src.dtype)
    return out.index_add_(0, seg, src)
def _pad(x, pw):
    flat = tuple(v for pair in reversed(pw) for v in pair)
    return torch.nn.functional.pad(x, flat)

kernel_name = 'recurrent_scan__sliding_block_cached__dense_activation_relu__decode'

def setup_inputs():

    _w = (lambda a: (lambda t: t.to(torch.bfloat16) if t.is_floating_point() else t)(torch.as_tensor(a)))
    def _A_setup():
        B, Sq, D = 1, 1, 512
        Hq, Hkv, Sk, Dh = 32, 8, 65536, 128
        assert Hq % Hkv == 0, (Hq, Hkv)
        return {
            "x": _w((lambda *s: torch.randn(*s, dtype=torch.bfloat16) * 0.05)(B, Sq, D)),
            "k_cache": _w((lambda *s: torch.randn(*s, dtype=torch.bfloat16) * 1.6)(B, Hkv, Sk, Dh)),
            "v_cache": _w((lambda *s: torch.randn(*s, dtype=torch.bfloat16) * 0.2)(B, Hkv, Sk, Dh)),
            "wq": _w((lambda *s: torch.randn(*s, dtype=torch.bfloat16) * 1.6)(D, Hq * Dh) * (D ** -0.5)),
            "wo": _w((lambda *s: torch.randn(*s, dtype=torch.bfloat16) * 0.2)(Hq * Dh, D) * ((Hq * Dh) ** -0.5)),
        }
    _A_in = _A_setup()

    def _B_setup():
        B, S, D, Dff = 1, 1, 512, 1792
        return {
            "x": _w((lambda *s: torch.randn(*s, dtype=torch.bfloat16) * 0.05)(B, S, D)),
            "w1": _w((lambda *s: torch.randn(*s, dtype=torch.bfloat16) * 0.1)(D, Dff)),
            "w2": _w((lambda *s: torch.randn(*s, dtype=torch.bfloat16) * 0.1)(Dff, D)),
        }
    _B_in = _B_setup()

    return {
        "A_x": _A_in["x"],
        "A_k_cache": _A_in["k_cache"],
        "A_v_cache": _A_in["v_cache"],
        "A_wq": _A_in["wq"],
        "A_wo": _A_in["wo"],
        "B_x": _B_in["x"],
        "B_w1": _B_in["w1"],
        "B_w2": _B_in["w2"],
    }

def reference(A_x, A_k_cache, A_v_cache, A_wq, A_wo, B_x, B_w1, B_w2):
    def _A_ref(x, k_cache, v_cache, wq, wo):
        B, Sq, D = x.shape
        Hq, Dh = 32, 128
        Hkv, Sk = k_cache.shape[1], k_cache.shape[2]
        W = min(4096, max(256, Sk // 4))
        rep = Hq // Hkv
        q = (lambda x, *d: x.permute(*d))((x @ wq).reshape(B, Sq, Hq, Dh), 0, 2, 1, 3)
        k = (lambda x, n, axis: torch.repeat_interleave(x, n, dim=axis))(k_cache[:, :, Sk - W:, :], rep, axis=1)
        v = (lambda x, n, axis: torch.repeat_interleave(x, n, dim=axis))(v_cache[:, :, Sk - W:, :], rep, axis=1)
        scores = torch.einsum("bhqd,bhkd->bhqk", q, k) * (Dh ** -0.5)
        p = _softmax(scores, axis=-1)
        o = torch.einsum("bhqk,bhkd->bhqd", p, v)
        return (lambda x, *d: x.permute(*d))(o, 0, 2, 1, 3).reshape(B, Sq, Hq * Dh) @ wo

    def _B_ref(x, w1, w2):
        h = torch.einsum("bsd,df->bsf", x, w1)
        zero = torch.zeros_like(h)
        h = torch.maximum(h, zero)
        return torch.einsum("bsf,fd->bsd", h, w2)

    x = A_x
    xn = _layernorm(x, axis=-1)
    s = _A_ref(xn, A_k_cache, A_v_cache, A_wq, A_wo)
    g = _silu(_B_ref(xn, B_w1, B_w2))
    return x + s * g
```

```asm
; @launch grid=(256,1,1) block=(512,1,1) lds=70656
.amdgcn_target "amdgcn-amd-amdhsa--gfx950"
.text
.globl recurrent_scan__sliding_block_cached__dense_activation_relu__decode_kernel
.p2align 8
.type recurrent_scan__sliding_block_cached__dense_activation_relu__decode_kernel,@function
recurrent_scan__sliding_block_cached__dense_activation_relu__decode_kernel:
    s_load_dwordx16 s[4:19], s[0:1], 0
    s_getpc_b64 s[38:39]
L_pc:
    v_lshrrev_b32 v59, 6, v0
    v_and_b32 v5, 7, v0
    v_lshl_add_u32 v59, v59, 3, v5
    v_lshlrev_b32 v59, 7, v59
    v_min_u32 v59, L_end-L_pc, v59
    global_load_dword v22, v59, s[38:39]
    s_load_dwordx4 s[20:23], s[0:1], 64
    s_load_dwordx2 s[24:25], s[0:1], 80
    s_cmp_ge_u32 s2, 256
    s_cbranch_scc1 L_end
    v_lshrrev_b32 v55, 6, v0
    v_and_b32 v1, 63, v0
    s_lshr_b32 s29, s2, 3
    v_readfirstlane_b32 s27, v55
    v_lshrrev_b32 v4, 3, v1
    v_lshlrev_b32 v56, 4, v1
    s_lshr_b32 s31, s29, 3
    s_lshl_b32 s35, s31, 3
    s_add_u32 s35, s35, s27
    s_lshl_b32 s36, s35, 5
    v_lshl_add_u32 v57, v4, 1, s36
    s_and_b32 s28, s2, 7
    s_and_b32 s30, s29, 7
    s_lshl_b32 s35, s35, 17
    s_lshl_b32 s36, s28, 3
    s_add_u32 s34, s36, s30
    s_lshl_b32 s36, s34, 7
    s_add_u32 s35, s35, s36
    v_lshlrev_b32 v6, 13, v4
    v_lshl_or_b32 v6, v5, 4, v6
    v_add_u32 v7, 0x10000, v6
    s_lshl_b32 s37, s28, 24
    s_lshl_b32 s36, s29, 15
    s_add_u32 s37, s37, s36
    s_lshl_b32 s36, s27, 12
    s_add_u32 s37, s37, s36
    s_add_u32 s37, s37, 15728640
    s_add_u32 s36, s36, 37888
    s_mov_b32 m0, s36
    v_and_b32 v2, 15, v1
    v_lshrrev_b32 v3, 4, v1
    v_xor_b32 v60, v2, v3
    v_lshlrev_b32 v60, 4, v60
    v_lshl_or_b32 v11, v3, 8, v60
    v_xor_b32 v12, 0x40, v11
    s_waitcnt lgkmcnt(0)
    global_load_dwordx4 v[72:75], v56, s[4:5]
    global_load_ushort v19, v57, s[4:5]
    global_load_ushort v20, v57, s[4:5] offset:16
    s_add_u32 s44, s10, s35
    s_addc_u32 s45, s11, 0
    s_add_u32 s40, s6, s37
    s_addc_u32 s41, s7, 0
    s_barrier
    global_load_dwordx4 v[76:79], v6, s[44:45] nt
    global_load_dwordx4 v[80:83], v7, s[44:45] nt
    s_load_dword s26, s[24:25], 0
    s_add_u32 s42, s8, s37
    s_addc_u32 s43, s9, 0
    v_xor_b32 v13, 0x80, v11
    v_xor_b32 v14, 0xc0, v11
    v_and_b32 v61, 1, v2
    v_lshlrev_b32 v61, 4, v61
    v_mov_b32 v62, 0xffff
    v_lshlrev_b32 v24, v61, v62
    v_bfe_u32 v61, v2, 1, 2
    v_cmp_eq_u32 s[60:61], 0, v61
    v_cmp_eq_u32 s[62:63], 1, v61
    v_cmp_eq_u32 s[64:65], 2, v61
    v_cmp_eq_u32 s[66:67], 3, v61
    v_mov_b32 v25, 0xffffff00
    v_cndmask_b32 v140, 0, v24, s[60:61]
    v_cndmask_b32 v141, 0, v24, s[62:63]
    v_cndmask_b32 v142, 0, v24, s[64:65]
    v_cndmask_b32 v143, 0, v24, s[66:67]
    v_lshl_or_b32 v15, v2, 8, v60
    v_add_u32 v15, s36, v15
    v_lshrrev_b32 v55, 1, v3
    v_lshrrev_b32 v56, 3, v2
    v_cmp_eq_u32 s[60:61], v55, v56
    v_mul_u32_u24 v26, 272, v55
    v_lshl_add_u32 v26, v5, 5, v26
    v_and_b32 v56, 1, v3
    v_lshl_add_u32 v26, v56, 4, v26
    s_mul_i32 s35, s27, 544
    v_add_u32 v26, s35, v26
    s_and_b32 s39, s27, 1
    s_lshl_b32 s39, s39, 7
    v_mul_u32_u24 v27, 272, v5
    v_lshl_add_u32 v27, v4, 4, v27
    v_add_u32 v27, s39, v27
    s_lshl_b32 s35, s28, 2
    s_add_u32 s35, s35, s31
    s_lshl_b32 s35, s35, 11
    s_lshl_b32 s38, s30, 8
    s_add_u32 s35, s35, s38
    s_add_u32 s35, s35, s39
    s_add_u32 s35, s35, 8192
    v_lshl_add_u32 v28, v4, 4, s35
    v_cmp_eq_u32 s[62:63], 0, v5
    s_waitcnt vmcnt(2)
    v_lshlrev_b32 v55, 16, v72
    v_and_b32 v56, 0xffff0000, v72
    v_lshlrev_b32 v57, 16, v73
    v_and_b32 v58, 0xffff0000, v73
    v_lshlrev_b32 v59, 16, v74
    v_and_b32 v60, 0xffff0000, v74
    v_lshlrev_b32 v61, 16, v75
    v_and_b32 v62, 0xffff0000, v75
    v_add_f32 v63, v55, v56
    v_add_f32 v64, v57, v58
    v_add_f32 v65, v59, v60
    v_add_f32 v66, v61, v62
    v_add_f32 v63, v63, v64
    v_add_f32 v65, v65, v66
    v_add_f32 v63, v63, v65
    s_nop 1
    v_add_f32_dpp v63, v63, v63 row_ror:8 row_mask:0xf bank_mask:0xf
    s_nop 1
    v_add_f32_dpp v63, v63, v63 row_ror:4 row_mask:0xf bank_mask:0xf
    s_nop 1
    v_add_f32_dpp v63, v63, v63 row_ror:2 row_mask:0xf bank_mask:0xf
    s_nop 1
    v_add_f32_dpp v63, v63, v63 row_ror:1 row_mask:0xf bank_mask:0xf
    v_mov_b32 v64, v63
    s_nop 1
    v_permlane32_swap_b32 v63, v64
    v_add_f32 v63, v63, v64
    v_mov_b32 v64, v63
    s_nop 1
    v_permlane16_swap_b32 v63, v64
    v_add_f32 v63, v63, v64
    v_mul_f32 v63, 0x3b000000, v63
    v_sub_f32 v55, v55, v63
    v_sub_f32 v56, v56, v63
    v_sub_f32 v57, v57, v63
    v_sub_f32 v58, v58, v63
    v_sub_f32 v59, v59, v63
    v_sub_f32 v60, v60, v63
    v_sub_f32 v61, v61, v63
    v_sub_f32 v62, v62, v63
    v_mul_f32 v65, v55, v55
    v_mul_f32 v66, v56, v56
    v_fmac_f32 v65, v57, v57
    v_fmac_f32 v66, v58, v58
    v_fmac_f32 v65, v59, v59
    v_fmac_f32 v66, v60, v60
    v_fmac_f32 v65, v61, v61
    v_fmac_f32 v66, v62, v62
    v_add_f32 v65, v65, v66
    s_nop 1
    v_add_f32_dpp v65, v65, v65 row_ror:8 row_mask:0xf bank_mask:0xf
    s_nop 1
    v_add_f32_dpp v65, v65, v65 row_ror:4 row_mask:0xf bank_mask:0xf
    s_nop 1
    v_add_f32_dpp v65, v65, v65 row_ror:2 row_mask:0xf bank_mask:0xf
    s_nop 1
    v_add_f32_dpp v65, v65, v65 row_ror:1 row_mask:0xf bank_mask:0xf
    v_mov_b32 v66, v65
    s_nop 1
    v_permlane32_swap_b32 v65, v66
    v_add_f32 v65, v65, v66
    v_mov_b32 v66, v65
    s_nop 1
    v_permlane16_swap_b32 v65, v66
    v_add_f32 v65, v65, v66
    v_mul_f32 v65, 0x3b000000, v65
    v_cvt_pk_bf16_f32 v63, v63, v63
    v_cvt_pk_bf16_f32 v65, v65, v65
    v_and_b32 v63, 0xffff0000, v63
    v_and_b32 v65, 0xffff0000, v65
    v_add_f32 v65, 0x3727c5ac, v65
    v_cvt_pk_bf16_f32 v65, v65, v65
    v_and_b32 v65, 0xffff0000, v65
    v_sqrt_f32 v65, v65
    s_nop 0
    v_cvt_pk_bf16_f32 v65, v65, v65
    v_and_b32 v65, 0xffff0000, v65
    v_rcp_f32 v66, v65
    v_mov_b32 v249, v63
    v_mov_b32 v250, v65
    v_mov_b32 v251, v66
    v_lshlrev_b32 v19, 16, v19
    v_lshlrev_b32 v20, 16, v20
    v_sub_f32 v19, v19, v249
    v_sub_f32 v20, v20, v249
    v_cvt_pk_bf16_f32 v19, v19, v19
    v_cvt_pk_bf16_f32 v20, v20, v20
    v_and_b32 v19, 0xffff0000, v19
    v_and_b32 v20, 0xffff0000, v20
    v_mul_f32 v55, v19, v251
    v_mul_f32 v56, v20, v251
    v_fma_f32 v57, -v55, v250, v19
    v_fma_f32 v58, -v56, v250, v20
    v_fmac_f32 v55, v57, v251
    v_fmac_f32 v56, v58, v251
    v_cvt_pk_bf16_f32 v19, v55, v55
    v_cvt_pk_bf16_f32 v20, v56, v56
    global_load_lds_dwordx4 v11, s[40:41] offset:0 nt
    v_and_b32 v144, v19, v140
    v_and_b32 v145, v19, v141
    v_and_b32 v146, v19, v142
    v_and_b32 v147, v19, v143
    v_and_b32 v148, v20, v140
    v_and_b32 v149, v20, v141
    v_and_b32 v150, v20, v142
    v_and_b32 v151, v20, v143
    s_waitcnt lgkmcnt(0)
    s_add_u32 s58, s26, 1
    s_and_b32 s58, s58, 0xff
    s_max_u32 s58, s58, 1
    s_mul_i32 s59, s58, 0x01010101
    s_getreg_b32 s3, hwreg(HW_REG_XCC_ID, 0, 4)
    s_lshl_b32 s3, s3, 8
    s_cmp_lg_u32 s27, 2
    s_cbranch_scc1 L_noxr
    s_or_b32 s35, s3, s58
    v_mov_b32 v244, s35
    v_mov_b32 v245, s59
    v_mov_b32 v246, s59
    v_mov_b32 v247, s59
    s_lshl_b32 s35, s28, 5
    s_add_u32 s35, s35, s29
    s_lshl_b32 s35, s35, 4
    s_add_u32 s35, s35, 2048
    v_mov_b32 v229, s35
    s_mov_b64 exec, 1
    global_store_dwordx4 v229, v[244:247], s[24:25] sc1
    s_mov_b64 exec, -1
L_noxr:
    s_waitcnt vmcnt(2)
    global_load_lds_dwordx4 v12, s[40:41] offset:1024 nt
    v_mfma_f32_16x16x32_bf16 v[132:135], v[144:147], v[76:79], 0
    s_waitcnt vmcnt(2)
    global_load_lds_dwordx4 v13, s[40:41] offset:2048 nt
    v_mfma_f32_16x16x32_bf16 v[132:135], v[148:151], v[80:83], v[132:135]
    s_nop 6
    s_mov_b64 exec, s[60:61]
    ds_write_b128 v26, v[132:135] offset:0
    s_mov_b64 exec, -1
    s_waitcnt lgkmcnt(0)
    s_barrier
    s_cmp_ge_u32 s27, 2
    s_cbranch_scc1 L_noq
    ds_read_b128 v[236:239], v27 offset:0
    ds_read_b128 v[240:243], v27 offset:2176
    s_waitcnt lgkmcnt(0)
    v_add_f32 v236, v236, v240
    v_add_f32 v237, v237, v241
    v_add_f32 v238, v238, v242
    v_add_f32 v239, v239, v243
    v_add_f32_dpp v236, v236, v236 quad_perm:[1,0,3,2] row_mask:0xf bank_mask:0xf
    v_add_f32_dpp v237, v237, v237 quad_perm:[1,0,3,2] row_mask:0xf bank_mask:0xf
    v_add_f32_dpp v238, v238, v238 quad_perm:[1,0,3,2] row_mask:0xf bank_mask:0xf
    v_add_f32_dpp v239, v239, v239 quad_perm:[1,0,3,2] row_mask:0xf bank_mask:0xf
    v_add_f32_dpp v236, v236, v236 quad_perm:[2,3,0,1] row_mask:0xf bank_mask:0xf
    v_add_f32_dpp v237, v237, v237 quad_perm:[2,3,0,1] row_mask:0xf bank_mask:0xf
    v_add_f32_dpp v238, v238, v238 quad_perm:[2,3,0,1] row_mask:0xf bank_mask:0xf
    v_add_f32_dpp v239, v239, v239 quad_perm:[2,3,0,1] row_mask:0xf bank_mask:0xf
    v_add_f32_dpp v236, v236, v236 row_half_mirror row_mask:0xf bank_mask:0xf
    v_add_f32_dpp v237, v237, v237 row_half_mirror row_mask:0xf bank_mask:0xf
    v_add_f32_dpp v238, v238, v238 row_half_mirror row_mask:0xf bank_mask:0xf
    v_add_f32_dpp v239, v239, v239 row_half_mirror row_mask:0xf bank_mask:0xf
    v_and_or_b32 v236, v236, v25, s58
    v_and_or_b32 v237, v237, v25, s58
    v_and_or_b32 v238, v238, v25, s58
    v_and_or_b32 v239, v239, v25, s58
    s_mov_b64 exec, s[62:63]
    global_store_dwordx4 v28, v[236:239], s[24:25] sc1
    s_mov_b64 exec, -1
L_noq:
    global_load_lds_dwordx4 v14, s[40:41] offset:3072 nt
    s_mul_hi_u32 s32, s2, 153391690
    s_mul_i32 s36, s32, 28
    s_sub_u32 s33, s2, s36
    s_lshl_b32 s36, s32, 7
    s_lshl_b32 s37, s27, 4
    s_add_u32 s36, s36, s37
    s_and_b32 s36, s36, 1023
    v_lshl_add_u32 v58, v4, 1, s36
    global_load_ushort v21, v58, s[4:5]
    s_lshl_b32 s35, s28, 5
    s_add_u32 s35, s35, s29
    s_lshl_b32 s36, s35, 2
    v_mov_b32 v54, s36
    global_load_dword v23, v54, s[4:5]
    s_lshr_b32 s36, s35, 6
    s_lshl_b32 s36, s36, 16
    s_and_b32 s37, s35, 63
    s_lshl_b32 s37, s37, 4
    s_add_u32 s36, s36, s37
    s_add_u32 s36, s36, 786432
    v_lshl_add_u32 v53, v1, 10, s36
    v_mul_u32_u24 v8, 3584, v4
    v_lshl_add_u32 v8, v5, 4, v8
    s_lshl_b32 s36, s32, 6
    s_lshl_b32 s37, s27, 3
    s_add_u32 s36, s36, s37
    s_mul_i32 s36, s36, 3584
    s_lshl_b32 s37, s33, 7
    s_add_u32 s56, s36, s37
    s_mov_b32 s48, s16
    s_mov_b32 s49, s17
    s_mov_b32 s50, 1835008
    s_mov_b32 s51, 0x00020000
    v_lshlrev_b32 v9, 10, v3
    v_lshl_or_b32 v9, v2, 4, v9
    v_lshlrev_b32 v232, 8, v3
    v_lshl_or_b32 v232, v2, 4, v232
    s_waitcnt vmcnt(5)
    buffer_load_dwordx4 v[84:87], v8, s[48:51], s56 offen nt
    v_lshlrev_b32 v10, 11, v3
    v_lshl_or_b32 v10, v2, 4, v10
    s_lshl_b32 s35, s34, 16
    s_lshl_b32 s36, s27, 13
    s_add_u32 s35, s35, s36
    s_lshl_b32 s36, s31, 8
    s_add_u32 s35, s35, s36
    s_add_u32 s46, s12, s35
    s_addc_u32 s47, s13, 0
    s_mul_i32 s35, s34, 28
    s_lshl_b32 s37, s27, 2
    s_add_u32 s35, s35, s37
    s_lshl_b32 s35, s35, 10
    s_add_u32 s35, s35, s36
    s_cmp_eq_u32 s27, 7
    s_cselect_b32 s57, 0x7fff0000, s35
    s_mov_b32 s52, s18
    s_mov_b32 s53, s19
    s_mov_b32 s54, 1835008
    s_mov_b32 s55, 0x00020000
    v_xor_b32 v16, 0x40, v15
    v_xor_b32 v17, 0x80, v15
    v_xor_b32 v18, 0xc0, v15
    s_lshl_b32 s35, s28, 9
    s_add_u32 s35, s35, 2048
    v_and_b32 v229, 31, v1
    v_lshl_add_u32 v229, v229, 4, s35
    s_lshl_b32 s35, s28, 13
    s_lshl_b32 s36, s27, 8
    s_add_u32 s35, s35, s36
    s_add_u32 s35, s35, 8192
    v_lshlrev_b32 v30, 11, v3
    v_lshl_add_u32 v30, v2, 4, v30
    v_add_u32 v30, s35, v30
    s_mul_i32 s38, s32, 7168
    s_lshl_b32 s35, s33, 8
    s_add_u32 s38, s38, s35
    s_add_u32 s38, s38, s39
    s_add_u32 s38, s38, 73728
    v_lshl_add_u32 v29, v4, 4, s38
    v_and_b32 v56, 1, v3
    v_cmp_eq_u32 s[12:13], 0, v56
    s_waitcnt vmcnt(5)
    global_load_dwordx4 v[104:107], v9, s[42:43] offset:0 nt
    s_lshr_b32 s35, s27, 1
    s_mul_i32 s35, s35, 320
    s_and_b32 s36, s27, 1
    s_lshl_b32 s36, s36, 7
    s_add_u32 s35, s35, s36
    s_add_u32 s35, s35, 8704
    v_lshlrev_b32 v31, 3, v2
    v_lshl_add_u32 v31, v3, 1, v31
    v_add_u32 v31, s35, v31
    v_lshrrev_b32 v33, 2, v2
    v_mul_u32_u24 v32, 320, v33
    v_lshl_add_u32 v32, v3, 4, v32
    v_lshlrev_b32 v35, 5, v33
    s_lshl_b32 s35, s27, 2
    v_add_u32 v34, s35, v35
    v_and_b32 v62, 0x33, v1
    v_cmp_eq_u32 s[64:65], 0, v62
    v_and_b32 v62, 2, v2
    v_cmp_eq_u32 s[10:11], 0, v62
    v_cmp_gt_u32 s[6:7], 8, v2
    s_cmp_eq_u32 s27, 7
    s_cselect_b32 s35, 16, 8
    v_cmp_le_u32 s[8:9], s35, v2
    s_nop 0
    v_cndmask_b32 v160, 0, v140, s[6:7]
    v_cndmask_b32 v164, 0, v140, s[8:9]
    v_cndmask_b32 v161, 0, v141, s[6:7]
    v_cndmask_b32 v165, 0, v141, s[8:9]
    v_cndmask_b32 v162, 0, v142, s[6:7]
    v_cndmask_b32 v166, 0, v142, s[8:9]
    v_cndmask_b32 v163, 0, v143, s[6:7]
    v_cndmask_b32 v167, 0, v143, s[8:9]
    s_mul_i32 s35, s27, 2176
    v_lshl_add_u32 v36, v1, 4, s35
    v_and_b32 v61, 3, v1
    v_cmp_eq_u32 s[66:67], 0, v61
    v_lshlrev_b32 v39, 5, v61
    v_and_b32 v61, 1, v1
    v_cmp_eq_u32 s[14:15], 0, v61
    v_mul_u32_u24 v37, 2176, v61
    v_lshrrev_b32 v60, 1, v1
    v_bfe_u32 v62, v1, 1, 1
    v_mul_u32_u24 v62, 1088, v62
    v_add_u32 v37, v62, v37
    v_lshrrev_b32 v62, 2, v1
    v_lshl_add_u32 v37, v62, 4, v37
    s_and_b32 s37, s27, 3
    s_lshl_b32 s35, s37, 8
    v_add_u32 v37, s35, v37
    s_lshl_b32 s35, s37, 9
    s_lshl_b32 s36, s28, 5
    s_add_u32 s36, s36, s29
    s_mul_i32 s36, s36, 2048
    s_add_u32 s36, s36, 196608
    s_add_u32 s35, s35, s36
    v_lshl_add_u32 v38, v60, 4, s35
    s_lshl_b32 s36, s28, 11
    s_lshl_b32 s35, s29, 4
    s_add_u32 s36, s36, s35
    s_add_u32 s36, s36, 753664
    v_lshl_add_u32 v40, v1, 9, s36
    s_lshl_b32 s35, s28, 5
    s_lshl_b32 s36, s37, 3
    s_add_u32 s35, s35, s36
    s_mul_i32 s35, s35, 2048
    s_add_u32 s35, s35, 196608
    v_mul_u32_u24 v41, 2048, v3
    s_lshl_b32 s36, s30, 8
    s_add_u32 s36, s36, s35
    v_lshl_add_u32 v41, v2, 4, v41
    v_add_u32 v41, s36, v41
    v_add_u32 v44, 8192, v41
    s_lshr_b32 s36, s30, 1
    s_lshl_b32 s36, s36, 9
    s_lshl_b32 s35, s28, 11
    s_add_u32 s36, s36, s35
    s_lshl_b32 s35, s37, 7
    s_add_u32 s36, s36, s35
    s_add_u32 s36, s36, 753664
    v_lshl_add_u32 v42, v3, 4, s36
    s_and_b32 s36, s27, 3
    s_lshl_b32 s36, s36, 3
    v_add_u32 v230, s36, v4
    v_min_u32 v43, 27, v230
    v_lshlrev_b32 v230, 1, v230
    s_mul_i32 s35, s34, 112
    s_add_u32 s35, s35, 73728
    v_lshl_add_u32 v43, v43, 2, s35
    v_mul_u32_u24 v60, 7168, v5
    v_add_u32 v43, v43, v60
    s_lshl_b32 s35, s27, 3
    v_lshl_add_u32 v231, v3, 1, s35
    s_and_b32 s37, s27, 3
    s_mul_i32 s35, s37, 288
    v_lshlrev_b32 v46, 4, v2
    v_lshl_add_u32 v46, v3, 2, v46
    v_add_u32 v46, s35, v46
    s_lshl_b32 s35, s37, 3
    v_mov_b32 v47, s35
    v_and_b32 v61, 3, v1
    v_mul_u32_u24 v48, 288, v61
    v_lshl_add_u32 v48, v3, 3, v48
    v_bfe_u32 v60, v2, 3, 1
    v_lshl_add_u32 v48, v60, 2, v48
    s_lshl_b32 s35, s27, 5
    v_add_u32 v48, s35, v48
    v_lshlrev_b32 v49, 3, v61
    v_lshrrev_b32 v50, 1, v3
    v_lshlrev_b32 v50, 9, v50
    v_lshl_add_u32 v50, v2, 5, v50
    v_and_b32 v60, 1, v3
    v_lshl_add_u32 v50, v60, 4, v50
    s_mul_i32 s35, s27, 1088
    v_add_u32 v50, s35, v50
    v_mul_u32_u24 v51, 1088, v61
    v_lshrrev_b32 v60, 2, v1
    v_lshl_add_u32 v51, v60, 3, v51
    s_lshl_b32 s35, s37, 7
    v_add_u32 v51, s35, v51
    s_lshl_b32 s35, s31, 6
    s_add_u32 s35, s35, s34
    s_lshl_b32 s35, s35, 10
    s_lshl_b32 s36, s37, 8
    s_add_u32 s35, s35, s36
    s_add_u32 s35, s35, 786432
    v_lshl_add_u32 v52, v60, 4, s35
    s_cmp_lt_u32 s27, 4
    s_cselect_b64 vcc, -1, 0
    v_cndmask_b32 v55, v42, v38, vcc
    v_cndmask_b32 v56, v29, v52, vcc
    global_load_dword v22, v55, s[24:25]
    global_load_dword v22, v56, s[24:25]
    s_mov_b32 s68, 0
    s_mov_b32 s69, 0
    s_waitcnt vmcnt(7)
    s_waitcnt vmcnt(6)
    global_load_dwordx4 v[224:227], v229, s[24:25] sc1
    global_load_dwordx4 v[200:203], v30, s[24:25] sc1
    s_barrier
    global_load_dwordx4 v[108:111], v9, s[42:43] offset:256 nt
    global_load_dwordx4 v[112:115], v9, s[42:43] offset:512 nt
    ds_read_b128 v[88:91], v15
    ds_read_b128 v[92:95], v16
    ds_read_b128 v[96:99], v17
    ds_read_b128 v[100:103], v18
    s_waitcnt vmcnt(9)
    v_lshlrev_b32 v21, 16, v21
    v_sub_f32 v21, v21, v249
    v_cvt_pk_bf16_f32 v21, v21, v21
    v_and_b32 v21, 0xffff0000, v21
    v_mul_f32 v55, v21, v251
    v_fma_f32 v56, -v55, v250, v21
    v_fmac_f32 v55, v56, v251
    v_cvt_pk_bf16_f32 v21, v55, v55
    v_and_b32 v152, v21, v140
    v_and_b32 v153, v21, v141
    v_and_b32 v154, v21, v142
    v_and_b32 v155, v21, v143
    s_waitcnt vmcnt(7)
    global_load_dwordx4 v[116:119], v9, s[42:43] offset:768 nt
    s_waitcnt vmcnt(3)
L_chk1:
    v_msad_u8 v60, v200, s58, 0
    v_msad_u8 v61, v201, s58, 0
    v_msad_u8 v62, v224, s58, 0
    v_msad_u8 v60, v202, s58, v60
    v_msad_u8 v61, v203, s58, v61
    v_msad_u8 v62, v225, s58, v62
    v_msad_u8 v62, v226, s58, v62
    v_msad_u8 v62, v227, s58, v62
    v_or3_b32 v60, v60, v61, v62
    v_cmp_ne_u32 vcc, 0, v60
    s_cbranch_vccz L_ok1l
    s_add_u32 s68, s68, 1
    s_cmp_ge_u32 s68, 0x40000
    s_cbranch_scc1 L_ok1l
    s_sleep 1
    global_load_dwordx4 v[224:227], v229, s[24:25] sc1
    global_load_dwordx4 v[200:203], v30, s[24:25] sc1
    s_waitcnt vmcnt(0)
    s_branch L_chk1
L_ok1l:
    v_mov_b32 v220, v200
    v_mov_b32 v221, v201
    v_mov_b32 v222, v202
    v_mov_b32 v223, v203
    s_add_u32 s68, s68, 100
L_ok1e:
    v_and_b32 v220, v220, v25
    v_and_b32 v221, v221, v25
    v_and_b32 v222, v222, v25
    v_and_b32 v223, v223, v25
    v_lshrrev_b32 v62, 8, v224
    v_and_b32 v62, 15, v62
    v_permlane32_swap_b32 v220, v222
    v_permlane32_swap_b32 v221, v223
    v_add_f32 v220, v220, v222
    v_add_f32 v221, v221, v223
    s_lshr_b32 s35, s3, 8
    v_cmp_ne_u32 vcc, s35, v62
    v_permlane16_swap_b32 v220, v221
    v_add_f32 v220, v220, v221
    v_cvt_pk_bf16_f32 v220, v220, v220
    ds_write_b16 v31, v220
    s_cmp_eq_u64 vcc, 0
    s_cselect_b32 s3, 1, 0
    s_waitcnt lgkmcnt(0)
    s_barrier
    ds_read_b128 v[168:171], v32 offset:8704
    ds_read_b128 v[172:175], v32 offset:8768
    ds_read_b128 v[176:179], v32 offset:8832
    ds_read_b128 v[180:183], v32 offset:8896
    s_waitcnt vmcnt(8)
    v_mfma_f32_16x16x32_bf16 v[136:139], v[152:155], v[84:87], 0
    s_waitcnt lgkmcnt(3)
    v_mfma_f32_16x16x32_bf16 v[184:187], v[88:91], v[168:171], 0
    s_waitcnt lgkmcnt(2)
    v_mfma_f32_16x16x32_bf16 v[184:187], v[92:95], v[172:175], v[184:187]
    s_waitcnt lgkmcnt(1)
    v_mfma_f32_16x16x32_bf16 v[184:187], v[96:99], v[176:179], v[184:187]
    s_waitcnt lgkmcnt(0)
    v_mfma_f32_16x16x32_bf16 v[184:187], v[100:103], v[180:183], v[184:187]
    buffer_load_dwordx4 v[120:123], v9, s[52:55], s57 offen nt
    s_mov_b64 exec, s[60:61]
    ds_write_b128 v26, v[136:139] offset:4352
    s_mov_b64 exec, -1
    s_nop 4
    v_cvt_pk_bf16_f32 v236, v184, v185
    v_cvt_pk_bf16_f32 v237, v186, v187
    v_lshlrev_b32 v63, 16, v236
    v_and_b32 v64, 0xffff0000, v236
    v_lshlrev_b32 v65, 16, v237
    v_and_b32 v66, 0xffff0000, v237
    v_mul_f32 v63, 0x3db504f3, v63
    v_mul_f32 v64, 0x3db504f3, v64
    v_mul_f32 v65, 0x3db504f3, v65
    v_mul_f32 v66, 0x3db504f3, v66
    v_cvt_pk_bf16_f32 v236, v63, v64
    v_cvt_pk_bf16_f32 v237, v65, v66
    v_lshlrev_b32 v63, 16, v236
    v_and_b32 v64, 0xffff0000, v236
    v_lshlrev_b32 v65, 16, v237
    v_and_b32 v66, 0xffff0000, v237
    v_max3_f32 v238, v63, v64, v65
    v_max_f32 v238, v238, v66
    v_mov_b32 v239, v238
    s_nop 1
    v_permlane32_swap_b32 v238, v239
    v_max_f32 v238, v238, v239
    v_mov_b32 v239, v238
    s_nop 1
    v_permlane16_swap_b32 v238, v239
    v_max_f32 v238, v238, v239
    s_mov_b64 exec, s[64:65]
    ds_write_b32 v34, v238 offset:9984
    s_mov_b64 exec, -1
    s_waitcnt lgkmcnt(0)
    s_barrier
    s_cmp_lt_u32 s27, 6
    s_cbranch_scc1 L_noh
    ds_read_b128 v[236:239], v27 offset:4352
    ds_read_b128 v[240:243], v27 offset:6528
    s_waitcnt lgkmcnt(0)
    v_add_f32 v236, v236, v240
    v_add_f32 v237, v237, v241
    v_add_f32 v238, v238, v242
    v_add_f32 v239, v239, v243
    v_add_f32_dpp v236, v236, v236 quad_perm:[1,0,3,2] row_mask:0xf bank_mask:0xf
    v_add_f32_dpp v237, v237, v237 quad_perm:[1,0,3,2] row_mask:0xf bank_mask:0xf
    v_add_f32_dpp v238, v238, v238 quad_perm:[1,0,3,2] row_mask:0xf bank_mask:0xf
    v_add_f32_dpp v239, v239, v239 quad_perm:[1,0,3,2] row_mask:0xf bank_mask:0xf
    v_add_f32_dpp v236, v236, v236 quad_perm:[2,3,0,1] row_mask:0xf bank_mask:0xf
    v_add_f32_dpp v237, v237, v237 quad_perm:[2,3,0,1] row_mask:0xf bank_mask:0xf
    v_add_f32_dpp v238, v238, v238 quad_perm:[2,3,0,1] row_mask:0xf bank_mask:0xf
    v_add_f32_dpp v239, v239, v239 quad_perm:[2,3,0,1] row_mask:0xf bank_mask:0xf
    v_add_f32_dpp v236, v236, v236 row_half_mirror row_mask:0xf bank_mask:0xf
    v_add_f32_dpp v237, v237, v237 row_half_mirror row_mask:0xf bank_mask:0xf
    v_add_f32_dpp v238, v238, v238 row_half_mirror row_mask:0xf bank_mask:0xf
    v_add_f32_dpp v239, v239, v239 row_half_mirror row_mask:0xf bank_mask:0xf
    v_and_or_b32 v236, v236, v25, s58
    v_and_or_b32 v237, v237, v25, s58
    v_and_or_b32 v238, v238, v25, s58
    v_and_or_b32 v239, v239, v25, s58
    s_mov_b64 exec, s[62:63]
    global_store_dwordx4 v29, v[236:239], s[24:25] sc1
    s_mov_b64 exec, -1
L_noh:
    ds_read_b128 v[240:243], v35 offset:9984
    ds_read_b128 v[244:247], v35 offset:10000
    global_load_dwordx4 v[124:127], v10, s[46:47] nt
    v_cndmask_b32 v60, 0, v24, s[10:11]
    v_cndmask_b32 v61, v24, 0, s[10:11]
    s_waitcnt lgkmcnt(0)
    v_max3_f32 v240, v240, v241, v242
    v_max3_f32 v244, v244, v245, v246
    v_max3_f32 v240, v240, v243, v247
    v_max_f32 v248, v240, v244
    v_sub_f32 v63, v63, v248
    v_sub_f32 v64, v64, v248
    v_sub_f32 v65, v65, v248
    v_sub_f32 v66, v66, v248
    v_mul_f32 v63, 0x3fb8aa3b, v63
    v_mul_f32 v64, 0x3fb8aa3b, v64
    v_mul_f32 v65, 0x3fb8aa3b, v65
    v_mul_f32 v66, 0x3fb8aa3b, v66
    v_exp_f32 v63, v63
    v_exp_f32 v64, v64
    v_exp_f32 v65, v65
    v_exp_f32 v66, v66
    v_cvt_pk_bf16_f32 v236, v63, v63
    v_cvt_pk_bf16_f32 v237, v64, v64
    v_cvt_pk_bf16_f32 v238, v65, v65
    v_cvt_pk_bf16_f32 v239, v66, v66
    v_and_b32 v144, v236, v60
    v_and_b32 v145, v236, v61
    v_and_b32 v146, v237, v60
    v_and_b32 v147, v237, v61
    v_and_b32 v148, v238, v60
    v_and_b32 v149, v238, v61
    v_and_b32 v150, v239, v60
    v_and_b32 v151, v239, v61
    v_add_f32 v63, v63, v64
    v_add_f32 v65, v65, v66
    v_add_f32 v63, v63, v65
    s_waitcnt vmcnt(9)
    v_mfma_f32_16x16x16_bf16 v[188:191], v[144:145], v[104:105], 0
    v_mfma_f32_16x16x16_bf16 v[192:195], v[144:145], v[106:107], 0
    global_load_dwordx4 v[128:131], v10, s[46:47] offset:1024 nt
    v_mov_b32 v64, v63
    s_nop 1
    v_permlane32_swap_b32 v63, v64
    v_add_f32 v63, v63, v64
    v_mov_b32 v64, v63
    s_nop 1
    v_permlane16_swap_b32 v63, v64
    v_add_f32 v63, v63, v64
    s_mov_b64 exec, s[64:65]
    ds_write_b32 v34, v63 offset:10112
    s_mov_b64 exec, -1
    s_waitcnt vmcnt(5)
    v_mfma_f32_16x16x16_bf16 v[188:191], v[146:147], v[108:109], v[188:191]
    v_mfma_f32_16x16x16_bf16 v[192:195], v[146:147], v[110:111], v[192:195]
    s_waitcnt vmcnt(4)
    v_mfma_f32_16x16x16_bf16 v[188:191], v[148:149], v[112:113], v[188:191]
    v_mfma_f32_16x16x16_bf16 v[192:195], v[148:149], v[114:115], v[192:195]
    s_waitcnt vmcnt(3)
    v_mfma_f32_16x16x16_bf16 v[188:191], v[150:151], v[116:117], v[188:191]
    v_mfma_f32_16x16x16_bf16 v[192:195], v[150:151], v[118:119], v[192:195]
    s_nop 7
    ds_write_b128 v36, v[188:191] offset:10240
    ds_write_b128 v36, v[192:195] offset:11328
    s_waitcnt lgkmcnt(0)
    s_barrier
    s_cmp_ge_u32 s27, 4
    s_cbranch_scc1 L_pollers
    ds_read_b128 v[236:239], v37 offset:10240
    ds_read_b128 v[240:243], v37 offset:14592
    ds_read_b128 v[244:247], v37 offset:18944
    ds_read_b128 v[248:251], v37 offset:23296
    s_waitcnt lgkmcnt(2)
    v_add_f32 v236, v236, v240
    v_add_f32 v237, v237, v241
    v_add_f32 v238, v238, v242
    v_add_f32 v239, v239, v243
    s_waitcnt lgkmcnt(0)
    v_add_f32 v244, v244, v248
    v_add_f32 v245, v245, v249
    v_add_f32 v246, v246, v250
    v_add_f32 v247, v247, v251
    v_add_f32 v236, v236, v244
    v_add_f32 v237, v237, v245
    v_add_f32 v238, v238, v246
    v_add_f32 v239, v239, v247
    v_add_f32_dpp v236, v236, v236 quad_perm:[1,0,3,2] row_mask:0xf bank_mask:0xf
    v_add_f32_dpp v237, v237, v237 quad_perm:[1,0,3,2] row_mask:0xf bank_mask:0xf
    v_add_f32_dpp v238, v238, v238 quad_perm:[1,0,3,2] row_mask:0xf bank_mask:0xf
    v_add_f32_dpp v239, v239, v239 quad_perm:[1,0,3,2] row_mask:0xf bank_mask:0xf
    v_and_or_b32 v236, v236, v25, s58
    v_and_or_b32 v237, v237, v25, s58
    v_and_or_b32 v238, v238, v25, s58
    v_and_or_b32 v239, v239, v25, s58
    s_mov_b64 exec, s[14:15]
    s_cmp_eq_u32 s3, 0
    s_cbranch_scc1 L_sto_far
    global_store_dwordx4 v38, v[236:239], s[24:25]
    s_branch L_sto_done
L_sto_far:
    global_store_dwordx4 v38, v[236:239], s[24:25] sc1
L_sto_done:
    s_mov_b64 exec, -1
    s_barrier
    global_load_dword v228, v43, s[24:25] sc1
    s_waitcnt vmcnt(0)
    s_mov_b32 s69, 0
L_hs:
    v_msad_u8 v68, v228, s58, 0
    v_cmp_ne_u32 vcc, 0, v68
    s_cbranch_vccz L_hok
    s_add_u32 s69, s69, 1
    s_cmp_ge_u32 s69, 0x40000
    s_cbranch_scc1 L_hok
    s_sleep 2
    global_load_dword v228, v43, s[24:25] sc1
    s_waitcnt vmcnt(0)
    s_branch L_hs
L_hok:
    v_and_b32 v67, v228, v25
    s_nop 1
    v_add_f32_dpp v67, v67, v67 quad_perm:[1,0,3,2] row_mask:0xf bank_mask:0xf
    s_nop 1
    v_add_f32_dpp v67, v67, v67 quad_perm:[2,3,0,1] row_mask:0xf bank_mask:0xf
    s_nop 1
    v_add_f32_dpp v67, v67, v67 row_half_mirror row_mask:0xf bank_mask:0xf
    v_max_f32 v67, 0, v67
    v_cvt_pk_bf16_f32 v67, v67, v67
    s_mov_b64 exec, s[62:63]
    ds_write_b16 v230, v67 offset:37568
    s_mov_b64 exec, -1
    s_branch L_b5
L_pollers:
    s_cmp_lg_u32 s27, 7
    s_cbranch_scc1 L_noml
    ds_read_b128 v[244:247], v39 offset:10112
    ds_read_b128 v[248:251], v39 offset:10128
    ds_read_b128 v[152:155], v39 offset:9984
    ds_read_b128 v[168:171], v39 offset:10000
    s_waitcnt lgkmcnt(0)
    v_add_f32 v244, v244, v245
    v_add_f32 v246, v246, v247
    v_add_f32 v248, v248, v249
    v_add_f32 v250, v250, v251
    v_max3_f32 v152, v152, v153, v154
    v_max3_f32 v168, v168, v169, v170
    v_add_f32 v244, v244, v246
    v_add_f32 v248, v248, v250
    v_max3_f32 v152, v152, v155, v171
    v_add_f32 v245, v244, v248
    v_max_f32 v244, v152, v168
    v_mov_b32 v246, s59
    v_mov_b32 v247, s59
    v_and_or_b32 v244, v244, v25, s58
    v_and_or_b32 v245, v245, v25, s58
    s_mov_b64 exec, 15
    s_cmp_eq_u32 s3, 0
    s_cbranch_scc1 L_stml_far
    global_store_dwordx4 v40, v[244:247], s[24:25]
    s_branch L_stml_done
L_stml_far:
    global_store_dwordx4 v40, v[244:247], s[24:25] sc1
L_stml_done:
    s_mov_b64 exec, -1
L_noml:
    s_mov_b32 s68, 0
    s_barrier
    global_load_dwordx4 v[208:211], v42, s[24:25] sc1
    global_load_dwordx4 v[216:219], v42, s[24:25] offset:64 sc1
    global_load_dwordx4 v[204:207], v41, s[24:25] sc1
    global_load_dwordx4 v[212:215], v44, s[24:25] sc1
    s_waitcnt vmcnt(0)
L_poll2m:
    v_msad_u8 v61, v208, s58, 0
    v_msad_u8 v62, v216, s58, 0
    v_msad_u8 v63, v204, s58, 0
    v_msad_u8 v64, v212, s58, 0
    v_msad_u8 v61, v209, s58, v61
    v_msad_u8 v62, v217, s58, v62
    v_msad_u8 v63, v205, s58, v63
    v_msad_u8 v64, v213, s58, v64
    v_msad_u8 v61, v210, s58, v61
    v_msad_u8 v62, v218, s58, v62
    v_msad_u8 v63, v206, s58, v63
    v_msad_u8 v64, v214, s58, v64
    v_msad_u8 v61, v211, s58, v61
    v_msad_u8 v62, v219, s58, v62
    v_msad_u8 v63, v207, s58, v63
    v_msad_u8 v64, v215, s58, v64
    v_or3_b32 v61, v61, v62, v63
    v_or_b32 v61, v61, v64
    v_cmp_ne_u32 vcc, 0, v61
    s_cbranch_vccz L_ok2x
    s_mov_b64 exec, vcc
    s_sleep 1
    global_load_dwordx4 v[208:211], v42, s[24:25] sc1
    global_load_dwordx4 v[216:219], v42, s[24:25] offset:64 sc1
    global_load_dwordx4 v[204:207], v41, s[24:25] sc1
    global_load_dwordx4 v[212:215], v44, s[24:25] sc1
    s_add_u32 s68, s68, 1
    s_waitcnt vmcnt(0)
    s_cmp_lt_u32 s68, 0x40000
    s_cbranch_scc1 L_poll2m
L_ok2x:
    s_mov_b64 exec, -1
L_ok2:
    v_and_b32 v61, 0xffff0000, v208
    v_and_b32 v62, 0xffff0000, v216
    v_and_b32 v65, v209, v25
    v_max_f32 v63, v61, v62
    v_max_f32 v64, v61, v62
    v_and_b32 v217, v217, v25
    v_and_b32 v204, v204, v25
    v_permlane32_swap_b32 v63, v64
    v_and_b32 v205, v205, v25
    v_max_f32 v63, v63, v64
    v_mov_b32 v64, v63
    v_and_b32 v206, v206, v25
    v_and_b32 v207, v207, v25
    v_permlane16_swap_b32 v63, v64
    v_and_b32 v212, v212, v25
    v_and_b32 v213, v213, v25
    v_and_b32 v214, v214, v25
    v_and_b32 v215, v215, v25
    v_max_f32 v236, v63, v64
    v_sub_f32 v61, v61, v236
    v_sub_f32 v62, v62, v236
    v_mul_f32 v61, 0x3fb8aa3b, v61
    v_mul_f32 v62, 0x3fb8aa3b, v62
    v_exp_f32 v61, v61
    v_exp_f32 v62, v62
    s_nop 0
    v_mul_f32 v204, v204, v61
    v_mul_f32 v205, v205, v61
    v_mul_f32 v206, v206, v61
    v_mul_f32 v207, v207, v61
    v_mul_f32 v65, v65, v61
    v_fmac_f32 v204, v212, v62
    v_fmac_f32 v205, v213, v62
    v_fmac_f32 v206, v214, v62
    v_fmac_f32 v207, v215, v62
    v_fmac_f32 v65, v217, v62
    v_permlane32_swap_b32 v204, v206
    v_mov_b32 v64, v65
    v_permlane32_swap_b32 v205, v207
    v_add_f32 v204, v204, v206
    v_permlane32_swap_b32 v65, v64
    v_add_f32 v205, v205, v207
    v_add_f32 v65, v65, v64
    v_mov_b32 v64, v65
    v_permlane16_swap_b32 v204, v205
    v_add_f32 v204, v204, v205
    v_permlane16_swap_b32 v65, v64
    ds_write_b32 v46, v204 offset:36352
    v_add_f32 v237, v65, v64
    s_mov_b64 exec, 1
    ds_write_b64 v47, v[236:237] offset:37504
    s_mov_b64 exec, -1
L_b5:
    s_waitcnt lgkmcnt(0)
    s_barrier
    ds_read_u16 v67, v231 offset:37568
    ds_read_b64 v[236:237], v49 offset:37504
    ds_read_b32 v238, v48 offset:36352
    s_waitcnt lgkmcnt(1)
    v_max_f32_dpp v239, v236, v236 quad_perm:[1,0,3,2] row_mask:0xf bank_mask:0xf
    v_lshl_or_b32 v67, v67, 16, v67
    v_and_b32 v156, v67, v164
    v_max_f32_dpp v239, v239, v239 quad_perm:[2,3,0,1] row_mask:0xf bank_mask:0xf
    v_and_b32 v157, v67, v165
    v_sub_f32 v236, v236, v239
    v_and_b32 v158, v67, v166
    v_mul_f32 v236, 0x3fb8aa3b, v236
    v_and_b32 v159, v67, v167
    v_exp_f32 v236, v236
    s_waitcnt vmcnt(0) lgkmcnt(0)
    v_mul_f32 v237, v237, v236
    v_mul_f32 v238, v238, v236
    v_mfma_f32_16x16x32_bf16 v[196:199], v[156:159], v[120:123], 0
    v_add_f32_dpp v237, v237, v237 quad_perm:[1,0,3,2] row_mask:0xf bank_mask:0xf
    v_add_f32_dpp v238, v238, v238 quad_perm:[1,0,3,2] row_mask:0xf bank_mask:0xf
    s_nop 0
    v_add_f32_dpp v237, v237, v237 quad_perm:[2,3,0,1] row_mask:0xf bank_mask:0xf
    v_add_f32_dpp v238, v238, v238 quad_perm:[2,3,0,1] row_mask:0xf bank_mask:0xf
    v_rcp_f32 v240, v237
    s_nop 0
    v_mul_f32 v241, v238, v240
    v_cvt_pk_bf16_f32 v241, v241, v241
    v_and_b32 v144, v241, v160
    v_and_b32 v145, v241, v161
    v_mov_b32_dpp v242, v241 row_ror:8 row_mask:0xf bank_mask:0xf
    v_and_b32 v146, v241, v162
    v_and_b32 v147, v241, v163
    v_and_b32 v148, v242, v160
    v_and_b32 v149, v242, v161
    v_mfma_f32_16x16x32_bf16 v[196:199], v[144:147], v[124:127], v[196:199]
    v_and_b32 v150, v242, v162
    v_and_b32 v151, v242, v163
    s_nop 1
    v_mfma_f32_16x16x32_bf16 v[196:199], v[148:151], v[128:131], v[196:199]
    s_nop 7
    ds_write_b128 v50, v[196:199] offset:27648
    s_waitcnt lgkmcnt(0)
    s_barrier
    s_cmp_lt_u32 s27, 4
    s_cbranch_scc1 L_nof
    ds_read_b64 v[236:237], v51 offset:27648
    ds_read_b64 v[238:239], v51 offset:28160
    ds_read_b64 v[240:241], v51 offset:32000
    ds_read_b64 v[242:243], v51 offset:32512
    s_waitcnt lgkmcnt(0)
    v_add_f32 v236, v236, v240
    v_add_f32 v237, v237, v241
    v_add_f32 v238, v238, v242
    v_add_f32 v239, v239, v243
    v_add_f32_dpp v236, v236, v236 quad_perm:[1,0,3,2] row_mask:0xf bank_mask:0xf
    v_add_f32_dpp v237, v237, v237 quad_perm:[1,0,3,2] row_mask:0xf bank_mask:0xf
    v_add_f32_dpp v238, v238, v238 quad_perm:[1,0,3,2] row_mask:0xf bank_mask:0xf
    v_add_f32_dpp v239, v239, v239 quad_perm:[1,0,3,2] row_mask:0xf bank_mask:0xf
    v_add_f32_dpp v236, v236, v236 quad_perm:[2,3,0,1] row_mask:0xf bank_mask:0xf
    v_add_f32_dpp v237, v237, v237 quad_perm:[2,3,0,1] row_mask:0xf bank_mask:0xf
    v_add_f32_dpp v238, v238, v238 quad_perm:[2,3,0,1] row_mask:0xf bank_mask:0xf
    v_add_f32_dpp v239, v239, v239 quad_perm:[2,3,0,1] row_mask:0xf bank_mask:0xf
    v_and_or_b32 v236, v236, v25, s58
    v_and_or_b32 v237, v237, v25, s58
    v_and_or_b32 v238, v238, v25, s58
    v_and_or_b32 v239, v239, v25, s58
    s_mov_b64 exec, s[66:67]
    global_store_dwordx4 v52, v[236:239], s[24:25] sc1
    s_mov_b64 exec, -1
L_nof:
    s_cmp_lg_u32 s27, 7
    s_cbranch_scc1 L_fin
    s_mov_b32 s68, 0
    s_waitcnt vmcnt(0)
L_poll3:
    global_load_dwordx4 v[236:239], v53, s[24:25] sc1
    s_waitcnt vmcnt(0)
    v_msad_u8 v60, v236, s58, 0
    v_msad_u8 v61, v237, s58, 0
    v_msad_u8 v60, v238, s58, v60
    v_msad_u8 v61, v239, s58, v61
    v_or_b32 v60, v60, v61
    v_cmp_ne_u32 vcc, 0, v60
    s_cbranch_vccz L_ok3
    s_mov_b64 exec, vcc
    s_sleep 1
    s_add_u32 s68, s68, 1
    s_cmp_lt_u32 s68, 0x40000
    s_cbranch_scc1 L_poll3
L_ok3:
    s_mov_b64 exec, -1
    v_and_b32 v236, v236, v25
    v_and_b32 v237, v237, v25
    v_and_b32 v238, v238, v25
    v_and_b32 v239, v239, v25
    v_lshlrev_b32 v242, 16, v23
    v_permlane32_swap_b32 v236, v238
    v_permlane32_swap_b32 v237, v239
    v_add_f32 v236, v236, v238
    v_add_f32 v237, v237, v239
    v_and_b32 v243, 0xffff0000, v23
    v_cndmask_b32 v242, v243, v242, s[12:13]
    v_permlane16_swap_b32 v236, v237
    v_add_f32 v236, v236, v237
    s_nop 1
    v_add_f32_dpp v236, v236, v236 row_ror:8 row_mask:0xf bank_mask:0xf
    s_nop 1
    v_add_f32_dpp v236, v236, v236 row_ror:4 row_mask:0xf bank_mask:0xf
    s_nop 1
    v_add_f32_dpp v236, v236, v236 row_ror:2 row_mask:0xf bank_mask:0xf
    s_nop 1
    v_add_f32_dpp v236, v236, v236 row_ror:1 row_mask:0xf bank_mask:0xf
    v_cvt_pk_bf16_f32 v236, v236, v236
    v_and_b32 v236, 0xffff0000, v236
    v_mov_b32 v237, v236
    s_nop 1
    v_permlane32_swap_b32 v236, v237
    v_mul_f32 v238, 0xbfb8aa3b, v237
    v_exp_f32 v238, v238
    s_nop 0
    v_add_f32 v238, 1.0, v238
    v_rcp_f32 v239, v238
    s_nop 0
    v_mul_f32 v240, v237, v239
    v_cvt_pk_bf16_f32 v240, v240, v240
    v_and_b32 v240, 0xffff0000, v240
    v_mul_f32 v240, v236, v240
    v_cvt_pk_bf16_f32 v240, v240, v240
    v_and_b32 v240, 0xffff0000, v240
    v_add_f32 v240, v242, v240
    v_mov_b32 v241, v240
    s_nop 1
    v_permlane16_swap_b32 v240, v241
    v_cvt_pk_bf16_f32 v240, v240, v241
    s_mov_b64 exec, 1
    global_store_dword v54, v240, s[20:21]
    s_cmp_lg_u32 s2, 0
    s_cbranch_scc1 L_fin
    v_mov_b32 v242, 0
    v_mov_b32 v243, s58
    global_store_dword v242, v243, s[24:25]
L_fin:
L_end:
    s_endpgm
.p2align 8
.section .rodata,"a"
.p2align 6
.amdhsa_kernel recurrent_scan__sliding_block_cached__dense_activation_relu__decode_kernel
  .amdhsa_next_free_vgpr 256
  .amdhsa_next_free_sgpr 102
  .amdhsa_accum_offset 256
  .amdhsa_group_segment_fixed_size 0
  .amdhsa_kernarg_size 88
  .amdhsa_user_sgpr_count 2
  .amdhsa_user_sgpr_kernarg_segment_ptr 1
  .amdhsa_system_sgpr_workgroup_id_x 1
  .amdhsa_float_denorm_mode_32 3
.end_amdhsa_kernel
```
